```python
import torch

def _softmax(x, axis=-1):
    return torch.softmax(x, dim=axis)
def _gelu(x):
    return torch.nn.functional.gelu(x, approximate="tanh")
def _silu(x):
    return torch.nn.functional.silu(x)
def _sigmoid(x):
    return torch.sigmoid(x)
def _layernorm(x, axis=-1, eps=1e-5):
    m = x.mean(dim=axis, keepdim=True)
    v = x.var(dim=axis, keepdim=True, unbiased=False)
    return (x - m) / torch.sqrt(v + eps)
def _scatter_add(tgt, idx, src, axis=0):
    return tgt.clone().index_add_(axis, idx, src)
def _segment_sum(src, seg, n):
    out = torch.zeros((n,) + src.shape[1:], dtype=src.dtype)
    return out.index_add_(0, seg, src)
def _pad(x, pw):
    flat = tuple(v for pair in reversed(pw) for v in pair)
    return torch.nn.functional.pad(x, flat)

kernel_name = 'standalone__instancenorm__sampling'

def setup_inputs():

    _w = (lambda a: (lambda t: t.to(torch.bfloat16) if t.is_floating_point() else t)(torch.as_tensor(a)))
    B, C, H, W = 32, 1024, 32, 32
    return {
        "x": _w(abs((lambda *s: torch.randn(*s, dtype=torch.bfloat16) * 0.05)(B, C, H, W))),
        "g": _w((lambda *s: torch.randn(*s, dtype=torch.bfloat16) * 0.05)(C) + 1.0),
        "b": _w((lambda *s: torch.randn(*s, dtype=torch.bfloat16) * 0.4)(C)),
    }

def reference(x, g, b):
    mu = x.mean(axis=(-2, -1), keepdims=True)
    var = ((x - mu) ** 2).mean(axis=(-2, -1), keepdims=True)
    xhat = (x - mu) / torch.sqrt(var + 1e-5)
    return xhat * g.reshape(1, -1, 1, 1) + b.reshape(1, -1, 1, 1)
```

```asm
; @launch grid=(512,1,1) block=(256,1,1) lds=0
.amdgcn_target "amdgcn-amd-amdhsa--gfx950"
.text
.globl standalone__instancenorm__sampling_kernel
.p2align 8
.type standalone__instancenorm__sampling_kernel,@function
standalone__instancenorm__sampling_kernel:
    s_load_dwordx8 s[4:11], s[0:1], 0
    s_load_dwordx4 s[12:15], s[0:1], 32
    s_cmp_ge_u32 s2, 512
    s_cbranch_scc1 L_end
    v_lshrrev_b32 v2, 6, v0
    v_and_b32 v3, 63, v0
    v_readfirstlane_b32 s3, v2
    v_lshlrev_b32 v3, 4, v3
    s_lshr_b32 s26, s2, 3
    s_mul_i32 s17, s3, 40
    s_and_b32 s17, s17, 0x38
    s_xor_b32 s26, s26, s17
    s_lshl_b32 s26, s26, 16
    s_and_b32 s17, s2, 4
    s_lshl_b32 s17, s17, 11
    s_or_b32 s26, s26, s17
    s_and_b32 s27, s2, 3
    s_lshl_b32 s16, s27, 3
    s_or_b32 s16, s16, s3
    s_lshl_b32 s16, s16, 11
    s_or_b32 s16, s16, s26
    v_add_u32 v1, s16, v3
    s_bfe_u32 s31, s16, 0x5000b
    s_bfe_u32 s17, s26, 0x50010
    s_lshl_b32 s17, s17, 6
    v_and_b32 v2, 31, v0
    v_lshl_add_u32 v2, v2, 1, s17
    v_mov_b32 v62, 0
    v_mov_b32 v63, 0
    s_and_b32 s16, s2, 6
    s_or_b32 s16, s16, s3
    s_lshl_b32 s16, s16, 8
    s_lshr_b32 s35, s2, 2
    s_or_b32 s35, s35, s27
    s_or_b32 s35, s35, s16
    s_lshl_b32 s18, s35, 16
    s_add_u32 s18, s18, 0x2004100
    s_lshr_b32 s16, s35, 1
    s_xor_b32 s16, s16, s35
    s_and_b32 s16, s16, 1
    s_lshl_b32 s16, s16, 13
    s_xor_b32 s17, s16, 0x2000
    s_cmp_ge_u32 s35, 7
    s_waitcnt lgkmcnt(0)
    s_cbranch_scc1 L_load0
    s_add_u32 s18, s4, s18
    s_addc_u32 s19, s5, 0
    s_load_dword s24, s[18:19], s16 glc
    s_load_dword s25, s[18:19], s17 glc
L_load0:
    global_load_dwordx4 v[4:7], v1, s[4:5] nt
    global_load_dwordx4 v[8:11], v1, s[4:5] offset:1024 nt
    global_load_short_d16_hi v62, v2, s[6:7]
    global_load_short_d16_hi v63, v2, s[8:9]
    s_cmp_gt_u32 s35, 7
    s_cbranch_scc1 L_novote
    s_cmp_eq_u32 s35, 7
    s_cbranch_scc1 L_init
    s_waitcnt lgkmcnt(1)
    s_getreg_b32 s17, hwreg(HW_REG_XCC_ID, 0, 2)
    s_lshr_b32 s16, s16, 11
    s_add_u32 s17, s17, s16
    s_sub_u32 s17, s17, s2
    v_lshlrev_b32 v36, 3, v3
    s_getreg_b32 s20, hwreg(HW_REG_IB_STS, 8, 4)
    s_cmp_lg_u32 s20, 0
    s_cselect_b32 s20, 0, 4
    s_add_u32 s17, s17, s20
    s_and_b32 s17, s17, 7
    s_lshl_b32 s17, s17, 2
    s_lshl_b32 s17, 1, s17
    v_mov_b32 v37, s17
    s_mov_b64 exec, 3
    global_atomic_add v36, v37, s[12:13] sc1
    s_mov_b64 exec, -1
    s_waitcnt vmcnt(1) lgkmcnt(0)
L_novote:
    s_lshl2_add_u32 s27, s27, s3
    s_mov_b32 s28, 0
    s_movk_i32 s36, 0x7fff
    v_mov_b32 v52, 0x3a803a80
    v_mov_b32 v53, 0x3a803a80
    v_mov_b32 v54, 0x3a803a80
    v_mov_b32 v55, 0x3a803a80
    v_and_b32 v2, 1, v0
    v_lshlrev_b32 v2, 4, v2
    v_mov_b32 v60, 0xffff
    v_lshlrev_b32 v2, v2, v60
    v_bfe_i32 v61, v0, 1, 1
    v_and_b32 v61, v61, v2
    v_xor_b32 v60, v61, v2
    v_and_b32 v56, 0x3f803f80, v60
    v_and_b32 v57, 0x3f803f80, v61
L_top:
    s_add_u32 s28, s28, 1
    s_add_u32 s27, s27, 16
    s_and_b32 s16, s28, 3
    s_lshl_b32 s16, s16, 1
    s_xor_b32 s33, s16, s27
    v_mov_b32 v2, v1
    s_mov_b32 s34, s31
    s_cmp_eq_u32 s28, 2
    s_cbranch_scc1 L_resolve
    s_cmp_eq_u32 s28, 12
    s_cbranch_scc1 L_chkinit
L_go:
    s_waitcnt vmcnt(2)
    v_mfma_f32_16x16x32_bf16 v[44:47], v[52:55], v[4:7], 0
    v_mfma_f32_16x16x32_bf16 v[44:47], v[52:55], v[8:11], v[44:47]
    s_waitcnt lgkmcnt(0)
    s_min_u32 s16, s29, 63
    s_add_u32 s16, s16, 208
    s_cmp_lt_u32 s28, 13
    s_cselect_b32 s33, s33, s16
    s_and_b32 s16, s33, 3
    s_and_b32 s17, s33, 12
    s_lshl1_add_u32 s16, s17, s16
    s_lshr_b32 s17, s33, 4
    v_add_f32_dpp v36, v44, v44 quad_perm:[1,0,3,2] row_mask:0xf bank_mask:0xf
    s_min_u32 s17, s17, 15
    s_lshl_b32 s17, s17, 11
    v_add_f32_dpp v36, v36, v36 quad_perm:[2,3,0,1] row_mask:0xf bank_mask:0xf
    s_or_b32 s16, s16, s17
    s_lshl_b32 s16, s16, 11
    v_add_f32_dpp v36, v36, v36 row_half_mirror row_mask:0xf bank_mask:0xf
    s_or_b32 s16, s16, s26
    v_add_u32 v1, s16, v3
    v_add_f32_dpp v36, v36, v36 row_mirror row_mask:0xf bank_mask:0xf
    v_cvt_pk_bf16_f32 v48, 0, -v36
    s_bfe_u32 s31, s16, 0x5000b
    v_mov_b32 v49, v48
    v_pk_mov_b32 v[50:51], v[48:49], v[48:49] op_sel:[0,0]
    s_sub_u32 s16, s33, 192
    s_cmp_ge_u32 s16, 64
    v_mfma_f32_4x4x4_16b_bf16 v[20:23], v[56:57], v[4:5], v[48:51]
    v_mfma_f32_4x4x4_16b_bf16 v[24:27], v[56:57], v[6:7], v[48:51]
    v_mfma_f32_4x4x4_16b_bf16 v[28:31], v[56:57], v[8:9], v[48:51]
    v_mfma_f32_4x4x4_16b_bf16 v[32:35], v[56:57], v[10:11], v[48:51]
    global_load_dwordx4 v[4:7], v1, s[4:5] nt
    global_load_dwordx4 v[8:11], v1, s[4:5] offset:1024 nt
    s_cbranch_scc1 L_nodraw
    s_mov_b32 s29, 1
    s_atomic_add s29, s[14:15], s30 glc
L_nodraw:
    v_cvt_pk_bf16_f32 v12, v20, v21
    v_cvt_pk_bf16_f32 v13, v22, v23
    v_cvt_pk_bf16_f32 v14, v24, v25
    v_cvt_pk_bf16_f32 v15, v26, v27
    v_mfma_f32_4x4x4_16b_bf16 v[20:23], v[56:57], v[12:13], 0
    v_cvt_pk_bf16_f32 v16, v28, v29
    v_cvt_pk_bf16_f32 v17, v30, v31
    v_mfma_f32_4x4x4_16b_bf16 v[24:27], v[56:57], v[14:15], 0
    v_cvt_pk_bf16_f32 v18, v32, v33
    v_cvt_pk_bf16_f32 v19, v34, v35
    v_mfma_f32_4x4x4_16b_bf16 v[28:31], v[56:57], v[16:17], 0
    v_pk_mul_f32 v[36:37], v[20:21], v[20:21]
    v_mfma_f32_4x4x4_16b_bf16 v[32:35], v[56:57], v[18:19], 0
    v_pk_mul_f32 v[38:39], v[22:23], v[22:23]
    v_cvt_pk_bf16_f32 v12, v36, v37
    v_pk_mul_f32 v[40:41], v[24:25], v[24:25]
    v_cvt_pk_bf16_f32 v13, v38, v39
    v_pk_mul_f32 v[42:43], v[26:27], v[26:27]
    v_cvt_pk_bf16_f32 v14, v40, v41
    v_pk_mul_f32 v[36:37], v[28:29], v[28:29]
    v_cvt_pk_bf16_f32 v15, v42, v43
    v_pk_mul_f32 v[38:39], v[30:31], v[30:31]
    v_cvt_pk_bf16_f32 v16, v36, v37
    v_mfma_f32_16x16x32_bf16 v[44:47], v[52:55], v[12:15], 0
    v_pk_mul_f32 v[40:41], v[32:33], v[32:33]
    v_cvt_pk_bf16_f32 v17, v38, v39
    v_pk_mul_f32 v[42:43], v[34:35], v[34:35]
    v_cvt_pk_bf16_f32 v18, v40, v41
    v_cvt_pk_bf16_f32 v19, v42, v43
    s_cmp_lg_u32 s28, 1
    s_cbranch_scc1 L_gb
    s_waitcnt vmcnt(2)
L_gb:
    v_mfma_f32_16x16x32_bf16 v[44:47], v[52:55], v[16:19], v[44:47]
    v_readlane_b32 s22, v62, s34
    v_readlane_b32 s24, v63, s34
    s_nop 3
    s_pack_hh_b32_b16 s22, s22, s22
    s_nop 0
    v_add_f32_dpp v36, v44, v44 quad_perm:[1,0,3,2] row_mask:0xf bank_mask:0xf
    v_and_b32 v58, s22, v60
    v_and_b32 v59, s22, v61
    v_add_f32_dpp v36, v36, v36 quad_perm:[2,3,0,1] row_mask:0xf bank_mask:0xf
    v_pk_mov_b32 v[48:49], s[24:25], s[24:25] op_sel:[0,0]
    v_pk_mov_b32 v[50:51], s[24:25], s[24:25] op_sel:[0,0]
    v_add_f32_dpp v36, v36, v36 row_half_mirror row_mask:0xf bank_mask:0xf
    s_nop 1
    v_add_f32_dpp v36, v36, v36 row_mirror row_mask:0xf bank_mask:0xf
    v_cvt_pk_bf16_f32 v36, 0, v36
    v_add_f32 v36, 0x3727c5ac, v36
    v_cvt_pk_bf16_f32 v36, 0, v36
    v_sqrt_f32 v36, v36
    s_nop 0
    v_cvt_pk_bf16_f32 v36, 0, v36
    v_rcp_f32 v36, v36
    s_nop 0
    v_pk_mul_f32 v[20:21], v[20:21], v[36:37] op_sel_hi:[1,0]
    v_pk_mul_f32 v[22:23], v[22:23], v[36:37] op_sel_hi:[1,0]
    v_pk_mul_f32 v[24:25], v[24:25], v[36:37] op_sel_hi:[1,0]
    v_pk_mul_f32 v[26:27], v[26:27], v[36:37] op_sel_hi:[1,0]
    v_pk_mul_f32 v[28:29], v[28:29], v[36:37] op_sel_hi:[1,0]
    v_pk_mul_f32 v[30:31], v[30:31], v[36:37] op_sel_hi:[1,0]
    v_pk_mul_f32 v[32:33], v[32:33], v[36:37] op_sel_hi:[1,0]
    v_pk_mul_f32 v[34:35], v[34:35], v[36:37] op_sel_hi:[1,0]
    v_cvt_pk_bf16_f32 v12, v20, v21
    v_cvt_pk_bf16_f32 v13, v22, v23
    v_cvt_pk_bf16_f32 v14, v24, v25
    v_cvt_pk_bf16_f32 v15, v26, v27
    v_mfma_f32_4x4x4_16b_bf16 v[20:23], v[58:59], v[12:13], 0
    v_cvt_pk_bf16_f32 v16, v28, v29
    v_cvt_pk_bf16_f32 v17, v30, v31
    v_mfma_f32_4x4x4_16b_bf16 v[24:27], v[58:59], v[14:15], 0
    v_cvt_pk_bf16_f32 v18, v32, v33
    v_cvt_pk_bf16_f32 v19, v34, v35
    v_mfma_f32_4x4x4_16b_bf16 v[28:31], v[58:59], v[16:17], 0
    s_nop 0
    v_mfma_f32_4x4x4_16b_bf16 v[32:35], v[58:59], v[18:19], 0
    v_cvt_pk_bf16_f32 v12, v20, v21
    v_cvt_pk_bf16_f32 v13, v22, v23
    v_cvt_pk_bf16_f32 v14, v24, v25
    v_cvt_pk_bf16_f32 v15, v26, v27
    v_mfma_f32_4x4x4_16b_bf16 v[20:23], v[56:57], v[12:13], v[48:51]
    v_cvt_pk_bf16_f32 v16, v28, v29
    v_cvt_pk_bf16_f32 v17, v30, v31
    v_mfma_f32_4x4x4_16b_bf16 v[24:27], v[56:57], v[14:15], v[48:51]
    v_cvt_pk_bf16_f32 v18, v32, v33
    v_cvt_pk_bf16_f32 v19, v34, v35
    v_mfma_f32_4x4x4_16b_bf16 v[28:31], v[56:57], v[16:17], v[48:51]
    s_cmp_lt_u32 s33, 256
    v_mfma_f32_4x4x4_16b_bf16 v[32:35], v[56:57], v[18:19], v[48:51]
    v_cvt_pk_bf16_f32 v12, v20, v21
    v_cvt_pk_bf16_f32 v13, v22, v23
    v_cvt_pk_bf16_f32 v14, v24, v25
    v_cvt_pk_bf16_f32 v15, v26, v27
    global_store_dwordx4 v2, v[12:15], s[10:11] sc0 sc1
    v_cvt_pk_bf16_f32 v16, v28, v29
    v_cvt_pk_bf16_f32 v17, v30, v31
    v_cvt_pk_bf16_f32 v18, v32, v33
    v_cvt_pk_bf16_f32 v19, v34, v35
    global_store_dwordx4 v2, v[16:19], s[10:11] offset:1024 sc0 sc1
    s_cbranch_scc1 L_top
    s_endpgm
L_resolve:
    s_load_dword s16, s[12:13], 0
    s_waitcnt lgkmcnt(0)
    s_add_u32 s17, s16, 0x44444444
    s_and_b32 s17, s17, 0x88888888
    s_cbranch_scc0 L_retry
L_won:
    s_ff1_i32_b32 s17, s17
    s_lshr_b32 s17, s17, 2
    s_add_u32 s17, s17, s2
    s_lshr_b32 s16, s26, 19
    s_xor_b32 s16, s16, s17
    s_and_b32 s16, s16, 4
    s_lshl_b32 s16, s16, 11
    s_andn2_b32 s26, s26, 0x2000
    s_or_b32 s26, s26, s16
L_ctr:
    s_lshr_b32 s16, s26, 15
    s_bfe_u32 s17, s26, 0x1000d
    s_or_b32 s16, s16, s17
    s_mul_i32 s30, s16, 256
    s_branch L_go
L_chkinit:
    s_movk_i32 s36, 0x7fff
    s_load_dword s16, s[12:13], 196
    s_waitcnt lgkmcnt(0)
L_chk2:
    s_cmp_lg_u32 s16, 0
    s_cbranch_scc1 L_go
    s_sub_u32 s36, s36, 1
    s_cbranch_scc1 L_go
    v_mov_b32 v38, 0
    global_load_dword v36, v38, s[12:13] offset:196 sc0 sc1
    s_waitcnt vmcnt(0)
    v_readfirstlane_b32 s16, v36
    s_branch L_chk2
L_retry:
    s_waitcnt vmcnt(2)
    s_load_dword s16, s[12:13], 128
    s_waitcnt lgkmcnt(0)
    s_add_u32 s17, s16, 0x44444444
    s_and_b32 s17, s17, 0x88888888
    s_cbranch_scc1 L_won
    s_mul_i32 s17, s16, 0x11111111
    s_lshr_b32 s17, s17, 28
    s_cmp_lt_u32 s17, 7
    s_cbranch_scc1 L_slow
    s_branch L_ctr
L_slow:
    s_sub_u32 s36, s36, 1
    s_cbranch_scc1 L_ctr
    v_mov_b32 v38, 0
    global_load_dword v36, v38, s[12:13] sc0 sc1
    s_waitcnt vmcnt(0)
    v_readfirstlane_b32 s16, v36
    s_nop 0
    s_add_u32 s17, s16, 0x44444444
    s_and_b32 s17, s17, 0x88888888
    s_cbranch_scc1 L_won
    s_mul_i32 s17, s16, 0x11111111
    s_lshr_b32 s17, s17, 28
    s_cmp_lt_u32 s17, 7
    s_cbranch_scc1 L_slow
    s_branch L_ctr
L_init:
    v_mul_u32_u24 v36, 32, v3
    v_mov_b32 v37, 0
    global_store_dword v36, v37, s[14:15] sc0 sc1
    global_store_dword v36, v37, s[14:15] offset:256 sc0 sc1
    v_mov_b32 v38, 1
    s_waitcnt vmcnt(0)
    s_mov_b64 exec, 1
    global_store_dword v37, v38, s[12:13] offset:196 sc0 sc1
    s_mov_b64 exec, -1
    s_branch L_novote
L_end:
s_endpgm
.section .rodata,"a"
.p2align 6
.amdhsa_kernel standalone__instancenorm__sampling_kernel
  .amdhsa_next_free_vgpr 64
  .amdhsa_next_free_sgpr 48
  .amdhsa_accum_offset 64
  .amdhsa_group_segment_fixed_size 0
  .amdhsa_kernarg_size 48
  .amdhsa_user_sgpr_count 2
  .amdhsa_user_sgpr_kernarg_segment_ptr 1
  .amdhsa_system_sgpr_workgroup_id_x 1
  .amdhsa_float_denorm_mode_32 3
.end_amdhsa_kernel
```
